```python
import torch

def _softmax(x, axis=-1):
    return torch.softmax(x, dim=axis)
def _gelu(x):
    return torch.nn.functional.gelu(x, approximate="tanh")
def _silu(x):
    return torch.nn.functional.silu(x)
def _sigmoid(x):
    return torch.sigmoid(x)
def _layernorm(x, axis=-1, eps=1e-5):
    m = x.mean(dim=axis, keepdim=True)
    v = x.var(dim=axis, keepdim=True, unbiased=False)
    return (x - m) / torch.sqrt(v + eps)
def _scatter_add(tgt, idx, src, axis=0):
    return tgt.clone().index_add_(axis, idx, src)
def _segment_sum(src, seg, n):
    out = torch.zeros((n,) + src.shape[1:], dtype=src.dtype)
    return out.index_add_(0, seg, src)
def _pad(x, pw):
    flat = tuple(v for pair in reversed(pw) for v in pair)
    return torch.nn.functional.pad(x, flat)

kernel_name = 'standalone__sliding_block_cached__decode'

def setup_inputs():

    _w = (lambda a: (lambda t: t.to(torch.bfloat16) if t.is_floating_point() else t)(torch.as_tensor(a)))
    B, Sq, D = 1, 1, 448
    Hq, Hkv, Sk, Dh = 16, 8, 65536, 256
    assert Hq % Hkv == 0, (Hq, Hkv)
    return {
        "x": _w((lambda *s: torch.randn(*s, dtype=torch.bfloat16) * 0.8)(B, Sq, D)),
        "k_cache": _w((lambda *s: torch.randn(*s, dtype=torch.bfloat16) * 0.8)(B, Hkv, Sk, Dh)),
        "v_cache": _w((lambda *s: torch.randn(*s, dtype=torch.bfloat16) * 0.05)(B, Hkv, Sk, Dh)),
        "wq": _w((lambda *s: torch.randn(*s, dtype=torch.bfloat16) * 0.8)(D, Hq * Dh) * (D ** -0.5)),
        "wo": _w((lambda *s: torch.randn(*s, dtype=torch.bfloat16) * 0.05)(Hq * Dh, D) * ((Hq * Dh) ** -0.5)),
    }

def reference(x, k_cache, v_cache, wq, wo):
    B, Sq, D = x.shape
    Hq, Dh = 16, 256
    Hkv, Sk = k_cache.shape[1], k_cache.shape[2]
    W = min(4096, max(256, Sk // 4))
    rep = Hq // Hkv
    q = (lambda x, *d: x.permute(*d))((x @ wq).reshape(B, Sq, Hq, Dh), 0, 2, 1, 3)
    k = (lambda x, n, axis: torch.repeat_interleave(x, n, dim=axis))(k_cache[:, :, Sk - W:, :], rep, axis=1)
    v = (lambda x, n, axis: torch.repeat_interleave(x, n, dim=axis))(v_cache[:, :, Sk - W:, :], rep, axis=1)
    scores = torch.einsum("bhqd,bhkd->bhqk", q, k) * (Dh ** -0.5)
    p = _softmax(scores, axis=-1)
    o = torch.einsum("bhqk,bhkd->bhqd", p, v)
    return (lambda x, *d: x.permute(*d))(o, 0, 2, 1, 3).reshape(B, Sq, Hq * Dh) @ wo
```

```asm
; @launch grid=(256,1,1) block=(512,1,1) lds=149760
.amdgcn_target "amdgcn-amd-amdhsa--gfx950"
.text
.globl standalone__sliding_block_cached__decode_kernel
.p2align 8
.type standalone__sliding_block_cached__decode_kernel,@function
standalone__sliding_block_cached__decode_kernel:
    s_cmpk_ge_u32 s2, 0x100
    s_cbranch_scc1 L_end
    s_load_dwordx16 s[4:19], s[0:1], 0
    v_lshrrev_b32 v2, 6, v0
    v_and_b32 v1, 63, v0
    v_readfirstlane_b32 s3, v2
    v_lshlrev_b32 v3, 2, v1
    v_add_u32 v3, 149184, v3
    v_mov_b32 v4, 0
    ds_write_b32 v3, v4
    s_and_b32 s20, s2, 7
    s_lshr_b32 s21, s2, 3
    s_and_b32 s22, s3, 3
    s_cmp_ge_u32 s3, 4
    s_cbranch_scc1 L_loader
    s_cmp_lg_u32 s22, 0
    s_cbranch_scc1 L_s_notq
    v_lshrrev_b32 v7, 3, v1
    v_and_b32 v8, 6, v7
    v_and_b32 v9, 7, v1
    v_xor_b32 v8, v8, v9
    v_lshlrev_b32 v8, 4, v8
    v_lshl_add_u32 v6, v7, 13, v8
    s_lshr_b32 s58, s21, 3
    s_and_b32 s59, s21, 7
    s_mul_i32 s24, s58, 917504
    s_lshl_b32 s25, s20, 3
    s_add_u32 s25, s25, s59
    s_lshl_b32 s25, s25, 7
    s_add_u32 s24, s24, s25
    s_mulk_i32 s58, 224
    v_lshlrev_b32 v9, 4, v1
    s_mov_b32 s27, 0
    s_movk_i32 s25, 1024
    s_mov_b32 s26, 65536
    s_mov_b32 s34, 909440
    s_mov_b32 s35, 0x20000
    s_movk_i32 s38, 896
    s_mov_b32 s39, 0x20000
    s_mov_b32 m0, 149440
    s_waitcnt lgkmcnt(0)
    s_add_u32 s32, s10, s24
    s_addc_u32 s33, s11, 0
    s_and_b32 s33, s33, 0xffff
    s_mov_b32 s36, s4
    s_and_b32 s37, s5, 0xffff
    s_mov_b64 exec, 0x3fff
    buffer_load_dwordx4 v9, s[36:39], s58 offen lds
    s_mov_b64 exec, -1
    s_mov_b32 m0, 131072
    s_nop 0
    L_dma_1:
    buffer_load_dwordx4 v6, s[32:35], s27 offen nt lds
    s_add_u32 m0, m0, s25
    s_add_u32 s27, s27, s26
    buffer_load_dwordx4 v6, s[32:35], s27 offen nt lds
    s_add_u32 m0, m0, s25
    s_add_u32 s27, s27, s26
    s_cmp_lt_u32 s27, 917504
    s_cbranch_scc1 L_dma_1
    s_barrier
    s_branch L_s0_post
L_loader:
    v_lshrrev_b32 v7, 5, v1
    v_and_b32 v8, 31, v1
    v_xor_b32 v8, v8, v7
    v_lshlrev_b32 v8, 4, v8
    v_lshl_add_u32 v2, v7, 9, v8
    s_lshl_b32 s58, s20, 9
    s_add_u32 s58, s58, s21
    s_lshl_b32 s58, s58, 16
    s_add_u32 s58, s58, 31457280
    s_lshl_b32 s59, s22, 14
    s_add_u32 s25, s58, s59
    s_lshl_b32 s41, s21, 11
    s_movk_i32 s43, 0x3fff
    s_and_b32 s41, s41, s43
    s_movk_i32 s42, 1024
    s_movk_i32 s46, 1024
    s_mov_b32 s44, 0
    s_mov_b32 s45, 32
    s_mov_b32 s40, 0
    s_mov_b32 m0, s59
    s_movk_i32 s34, 16384
    s_mov_b32 s35, 0x20000
    v_mov_b32 v3, v2
    s_waitcnt lgkmcnt(0)
    s_add_u32 s32, s6, s25
    s_addc_u32 s33, s7, 0
    s_and_b32 s33, s33, 0xffff
    L_ld_2:
    s_cmp_lg_u32 s40, 8
    s_cbranch_scc1 L_b0_8
    s_barrier
L_b0_8:
    s_cmp_lt_u32 s40, 8
    s_cbranch_scc1 L_iss_3
    s_waitcnt vmcnt(7)
    s_cmp_eq_u32 s40, 16
    s_cbranch_scc1 L_sigh_4
    s_cmp_eq_u32 s40, 19
    s_cbranch_scc1 L_sigh_4
    s_cmp_eq_u32 s40, 23
    s_cbranch_scc1 L_sigk_5
    s_cmp_eq_u32 s40, 10
    s_cbranch_scc1 L_l_setup
    L_iss_3:
    v_xor_b32 v4, s44, v3
    s_add_u32 s44, s44, s45
    s_and_b32 s44, s44, 0xe0
    buffer_load_dwordx4 v4, s[32:35], s41 offen nt lds
    s_add_u32 s41, s41, s42
    s_and_b32 s41, s41, s43
    s_add_u32 m0, m0, s46
    s_add_u32 s40, s40, 1
    s_cmp_eq_u32 s40, 16
    s_cbranch_scc1 L_tov_6
    L_nx_7:
    s_cmp_lt_u32 s40, 32
    s_cbranch_scc1 L_ld_2
    s_branch L_l_rest
L_sigh_4:
    v_mov_b32 v5, 149184
    v_mov_b32 v6, 1
    s_mov_b64 exec, 1
    ds_add_u32 v5, v6 offset:12
    s_mov_b64 exec, -1
    s_branch L_iss_3
L_sigk_5:
    s_mov_b64 exec, 1
    v_mov_b32 v7, s22
    v_lshl_add_u32 v7, v7, 2, v5
    ds_write_b32 v7, v6 offset:24
    s_mov_b64 exec, -1
    s_branch L_iss_3
L_tov_6:
    v_lshrrev_b32 v7, 3, v1
    v_and_b32 v8, 6, v7
    v_and_b32 v9, 7, v1
    v_xor_b32 v8, v8, v9
    v_lshlrev_b32 v8, 4, v8
    v_lshl_add_u32 v3, v7, 9, v8
    s_lshl_b32 s26, s22, 7
    s_add_u32 s27, s58, s26
    s_add_u32 s32, s8, s27
    s_addc_u32 s33, s9, 0
    s_and_b32 s33, s33, 0xffff
    s_sub_u32 s34, 65536, s26
    s_mov_b32 s35, 0x20000
    s_mov_b32 s57, s21
    s_and_b32 s57, s57, 15
    s_lshl_b32 s41, s57, 12
    s_movk_i32 s42, 4096
    s_mov_b32 s43, 0xffff
    s_mov_b32 s44, 0
    s_mov_b32 s45, 0
    s_add_u32 s60, s59, 65536
    s_mov_b32 m0, s60
    s_branch L_nx_7
L_s_notq:
    s_cmp_eq_u32 s22, 1
    s_cbranch_scc1 L_s1_start
    s_cmp_lg_u32 s22, 2
    s_cbranch_scc1 L_pf_9
    s_cmp_ge_u32 s21, 4
    s_cbranch_scc1 L_pf_9
    s_getpc_b64 s[40:41]
        L_pc:
    s_sub_u32 s40, s40, L_pc-standalone__sliding_block_cached__decode_kernel
    s_subb_u32 s41, s41, 0
    s_and_b32 s41, s41, 0xffff
    s_mov_b32 s42, L_end+4-standalone__sliding_block_cached__decode_kernel
    s_mov_b32 s43, 0x20000
    v_lshlrev_b32 v7, 7, v1
    buffer_load_dword v153, v7, s[40:43], 0 offen
L_pf_9:
    v_lshlrev_b32 v7, 3, v1
    v_add_u32 v7, 148480, v7
    v_mov_b32 v112, -1
    v_mov_b32 v113, -1
    ds_write_b64 v7, v[112:113]
    v_lshlrev_b32 v7, 2, v1
    v_add_u32 v7, 148992, v7
    s_mov_b32 exec_hi, 0xffff
    ds_write_b32 v7, v112
    s_mov_b64 exec, -1
    s_waitcnt lgkmcnt(0)
    s_barrier
    s_branch L_s23_post
L_s1_start:
    v_mov_b32 v112, -1
    v_mov_b32 v113, -1
    v_mov_b32 v114, -1
    v_mov_b32 v115, -1
    v_lshrrev_b32 v7, 2, v1
    v_and_b32 v8, 3, v1
    v_lshlrev_b32 v8, 4, v8
    v_lshl_add_u32 v6, v7, 11, v8
    v_lshrrev_b32 v7, 3, v1
    v_and_b32 v8, 7, v1
    v_lshlrev_b32 v8, 4, v8
    v_lshl_add_u32 v7, v7, 13, v8
    v_lshlrev_b32 v9, 8, v1
    s_lshl_b32 s58, s20, 10
    s_add_u32 s58, s58, s21
    s_lshl_b32 s58, s58, 6
    s_add_u32 s58, s58, 524288
    s_lshl_b32 s60, s20, 6
    s_add_u32 s60, s60, s21
    s_lshl_b32 s60, s60, 3
    s_add_u32 s60, s60, 147456
    s_and_b32 s26, s21, 3
    s_lshl_b32 s59, s26, 15
    s_lshr_b32 s25, s21, 2
    s_lshl_b32 s27, s20, 3
    s_add_u32 s25, s25, s27
    s_lshl_b32 s25, s25, 7
    s_add_u32 s59, s59, s25
    s_add_u32 s59, s59, 196608
    s_mov_b32 s27, 32768
    s_mov_b32 s30, 1572864
    s_mov_b32 s31, 0x20000
    s_waitcnt lgkmcnt(0)
    s_mov_b32 s28, s18
    s_and_b32 s29, s19, 0xffff
    buffer_store_dwordx4 v[112:115], v6, s[28:31], s58 offen
    s_add_u32 s58, s58, s27
    buffer_store_dwordx4 v[112:115], v6, s[28:31], s58 offen
    s_mov_b64 exec, 3
    buffer_store_dwordx2 v[112:113], v9, s[28:31], s60 offen
    s_cmp_eq_u32 s26, 3
    s_cselect_b32 exec_lo, 0xffff, -1
    s_mov_b32 exec_hi, 0
    buffer_store_dwordx4 v[112:115], v7, s[28:31], s59 offen sc1
    s_mov_b64 exec, -1
    s_barrier
    s_branch L_s1_post
L_s0_post:
    s_load_dword s23, s[18:19], 0
    s_setprio 2
    v_lshrrev_b32 v2, 4, v1
    v_and_b32 v3, 15, v1
    v_mov_b32 v4, 149184
    v_mov_b32 v5, 1
    s_getreg_b32 s96, hwreg(HW_REG_XCC_ID)
    s_and_b32 s96, s96, 7
    s_mov_b32 s62, 0
    s_mov_b32 s98, 4096
    v_lshlrev_b32 v152, 3, v1
    s_mov_b32 s28, s18
    s_and_b32 s29, s19, 0xffff
    s_mov_b32 s30, 1572864
    s_mov_b32 s31, 0x20000
    s_mov_b32 s27, 131072
    v_lshrrev_b32 v7, 2, v1
    v_and_b32 v8, 7, v7
    v_lshrrev_b32 v7, 5, v1
    v_lshlrev_b32 v7, 10, v7
    v_lshlrev_b32 v9, 7, v8
    v_add_u32 v7, v7, v9
    v_and_b32 v9, 1, v1
    v_lshlrev_b32 v9, 3, v9
    v_add_u32 v7, v7, v9
    v_add_u32 v7, s27, v7
    v_and_b32 v8, 6, v8
    v_bfe_u32 v9, v1, 1, 1
    v_or_b32 v8, v8, v9
    v_xor_b32 v9, 0, v8
    v_lshlrev_b32 v9, 4, v9
    v_add_u32 v10, v7, v9
    v_xor_b32 v9, 2, v8
    v_lshlrev_b32 v9, 4, v9
    v_add_u32 v11, v7, v9
    v_xor_b32 v9, 4, v8
    v_lshlrev_b32 v9, 4, v9
    v_add_u32 v12, v7, v9
    v_xor_b32 v9, 6, v8
    v_lshlrev_b32 v9, 4, v9
    v_add_u32 v13, v7, v9
    v_mov_b32 v30, 0
    v_mov_b32 v31, 0
    v_mov_b32 v46, 0
    v_mov_b32 v47, 0
    v_mov_b32 v62, 0
    v_mov_b32 v63, 0
    v_mov_b32 v78, 0
    v_mov_b32 v79, 0
    v_mov_b32 v94, 0
    v_mov_b32 v95, 0
    s_mov_b32 s50, 0xffff0000
    s_mov_b32 s51, 0
    s_mov_b32 s52, 0
    s_mov_b32 s53, 0xffff
    s_mov_b32 s54, 0
    s_mov_b32 s55, 0xffff0000
    s_lshr_b32 s58, s21, 3
    s_lshl_b32 s98, s20, 14
    s_lshl_b32 s25, s58, 12
    s_add_u32 s98, s98, s25
    s_lshl_b32 s25, s59, 9
    s_add_u32 s98, s98, s25
    s_add_u32 s98, s98, 4096
    v_lshlrev_b32 v14, 3, v2
    v_add_u32 v14, 149440, v14
    s_mov_b32 s48, 0
L_spin_10:
    ds_read_b32 v7, v4 offset:48
    s_waitcnt lgkmcnt(0)
    v_readfirstlane_b32 s49, v7
    s_cmp_ge_u32 s49, 1
    s_cbranch_scc1 L_spun_11
    s_add_u32 s48, s48, 1
    s_cmp_lt_u32 s48, 65536
    s_sleep 1
    s_cbranch_scc1 L_spin_10
L_spun_11:
    s_waitcnt vmcnt(0)
    ds_read_b64 v[16:17], v14 offset:0
    ds_read_b64 v[18:19], v14 offset:32
    ds_read_b64 v[20:21], v14 offset:64
    ds_read_b64 v[22:23], v14 offset:96
    ds_read_b64 v[24:25], v14 offset:128
    ds_read_b64 v[26:27], v14 offset:160
    ds_read_b64 v[28:29], v14 offset:192
    ds_read_b64_tr_b16 v[32:33], v10 offset:0
    ds_read_b64_tr_b16 v[34:35], v10 offset:2048
    ds_read_b64_tr_b16 v[36:37], v10 offset:4096
    ds_read_b64_tr_b16 v[38:39], v10 offset:6144
    ds_read_b64_tr_b16 v[40:41], v10 offset:8192
    ds_read_b64_tr_b16 v[42:43], v10 offset:10240
    ds_read_b64_tr_b16 v[44:45], v10 offset:12288
    s_waitcnt lgkmcnt(7)
    ds_read_b64_tr_b16 v[48:49], v11 offset:0
    ds_read_b64_tr_b16 v[50:51], v11 offset:2048
    ds_read_b64_tr_b16 v[52:53], v11 offset:4096
    ds_read_b64_tr_b16 v[54:55], v11 offset:6144
    ds_read_b64_tr_b16 v[56:57], v11 offset:8192
    ds_read_b64_tr_b16 v[58:59], v11 offset:10240
    ds_read_b64_tr_b16 v[60:61], v11 offset:12288
    s_waitcnt lgkmcnt(7)
    v_mfma_f32_16x16x32_bf16 v[96:99], v[16:19], v[32:35], 0
    v_mfma_f32_16x16x32_bf16 v[96:99], v[20:23], v[36:39], v[96:99]
    v_mfma_f32_16x16x32_bf16 v[96:99], v[24:27], v[40:43], v[96:99]
    v_mfma_f32_16x16x32_bf16 v[96:99], v[28:31], v[44:47], v[96:99]
    ds_read_b64_tr_b16 v[64:65], v12 offset:0
    ds_read_b64_tr_b16 v[66:67], v12 offset:2048
    ds_read_b64_tr_b16 v[68:69], v12 offset:4096
    ds_read_b64_tr_b16 v[70:71], v12 offset:6144
    ds_read_b64_tr_b16 v[72:73], v12 offset:8192
    ds_read_b64_tr_b16 v[74:75], v12 offset:10240
    ds_read_b64_tr_b16 v[76:77], v12 offset:12288
    s_waitcnt lgkmcnt(7)
    v_mfma_f32_16x16x32_bf16 v[100:103], v[16:19], v[48:51], 0
    v_mfma_f32_16x16x32_bf16 v[100:103], v[20:23], v[52:55], v[100:103]
    v_mfma_f32_16x16x32_bf16 v[100:103], v[24:27], v[56:59], v[100:103]
    v_mfma_f32_16x16x32_bf16 v[100:103], v[28:31], v[60:63], v[100:103]
    ds_read_b64_tr_b16 v[80:81], v13 offset:0
    ds_read_b64_tr_b16 v[82:83], v13 offset:2048
    ds_read_b64_tr_b16 v[84:85], v13 offset:4096
    ds_read_b64_tr_b16 v[86:87], v13 offset:6144
    ds_read_b64_tr_b16 v[88:89], v13 offset:8192
    ds_read_b64_tr_b16 v[90:91], v13 offset:10240
    ds_read_b64_tr_b16 v[92:93], v13 offset:12288
    s_waitcnt lgkmcnt(7)
    v_mfma_f32_16x16x32_bf16 v[104:107], v[16:19], v[64:67], 0
    v_mfma_f32_16x16x32_bf16 v[104:107], v[20:23], v[68:71], v[104:107]
    v_mfma_f32_16x16x32_bf16 v[104:107], v[24:27], v[72:75], v[104:107]
    v_mfma_f32_16x16x32_bf16 v[104:107], v[28:31], v[76:79], v[104:107]
    s_waitcnt lgkmcnt(0)
    v_mfma_f32_16x16x32_bf16 v[108:111], v[16:19], v[80:83], 0
    v_mfma_f32_16x16x32_bf16 v[108:111], v[20:23], v[84:87], v[108:111]
    v_mfma_f32_16x16x32_bf16 v[108:111], v[24:27], v[88:91], v[108:111]
    v_mfma_f32_16x16x32_bf16 v[108:111], v[28:31], v[92:95], v[108:111]
    s_mul_i32 s23, s23, 0x9E3779B1
    s_add_u32 s23, s23, 0x7F4A7C15
    v_mov_b32 v151, s23
    s_mov_b32 s62, 1
    v_cndmask_b32 v150, v96, v100, s[50:51]
    v_cndmask_b32 v150, v150, v104, s[52:53]
    s_nop 4
    v_cndmask_b32 v150, v150, v108, s[54:55]
    v_and_b32 v150, -8, v150
    v_or_b32 v150, s96, v150
    buffer_store_dwordx2 v[150:151], v152, s[28:31], s98 offen
    s_mov_b64 exec, 1
    ds_write_b32 v4, v5 offset:64
    s_mov_b64 exec, -1
    s_branch L_s_common
L_s1_post:
    s_load_dword s23, s[18:19], 0
    s_setprio 2
    v_lshrrev_b32 v2, 4, v1
    v_and_b32 v3, 15, v1
    v_mov_b32 v4, 149184
    v_mov_b32 v5, 1
    s_getreg_b32 s96, hwreg(HW_REG_XCC_ID)
    s_and_b32 s96, s96, 7
    s_mov_b32 s62, 0
    s_mov_b32 s98, 4096
    v_lshlrev_b32 v152, 3, v1
    s_waitcnt vmcnt(1) lgkmcnt(0)
    s_mov_b64 exec, 1
    ds_add_u32 v4, v5 offset:48
    s_mov_b64 exec, -1
    s_mul_i32 s23, s23, 0x9E3779B1
    s_add_u32 s23, s23, 0x7F4A7C15
    s_mov_b64 exec, 1
    v_mov_b32 v8, 0
    v_mov_b32 v9, s23
    v_mov_b32 v6, 0
    s_lshl_b32 s24, s20, 8
    s_lshl_b32 s25, s21, 3
    s_add_u32 s24, s24, s25
    s_add_u32 s24, s24, 139264
    s_waitcnt vmcnt(0)
    buffer_store_dwordx2 v[8:9], v6, s[28:31], s24 offen sc1
    s_mov_b64 exec, -1
    s_branch L_s_common
L_s23_post:
    s_load_dword s23, s[18:19], 0
    s_setprio 2
    v_lshrrev_b32 v2, 4, v1
    v_and_b32 v3, 15, v1
    v_mov_b32 v4, 149184
    v_mov_b32 v5, 1
    s_getreg_b32 s96, hwreg(HW_REG_XCC_ID)
    s_and_b32 s96, s96, 7
    s_mov_b32 s62, 0
    s_mov_b32 s98, 4096
    v_lshlrev_b32 v152, 3, v1
    s_mov_b32 s28, s18
    s_and_b32 s29, s19, 0xffff
    s_mov_b32 s30, 1572864
    s_mov_b32 s31, 0x20000
    s_waitcnt lgkmcnt(0)
    s_mul_i32 s23, s23, 0x9E3779B1
    s_add_u32 s23, s23, 0x7F4A7C15
L_s_common:
    s_mul_i32 s56, s21, 2
    s_and_b32 s56, s56, 15
    s_and_b32 s56, s56, 14
    v_lshlrev_b32 v10, 4, v1
    s_lshl_b32 s58, s20, 14
    s_lshl_b32 s24, s22, 10
    s_add_u32 s58, s58, s24
    s_add_u32 s58, s58, 4096
    s_lshr_b32 s24, s2, 3
    v_and_b32 v7, 7, v1
    v_lshlrev_b32 v7, 2, v7
    v_add_u32 v7, s24, v7
    v_lshlrev_b32 v7, 3, v7
    v_lshrrev_b32 v8, 3, v1
    v_lshlrev_b32 v8, 8, v8
    v_add_u32 v7, v7, v8
    v_add_u32 v148, 139264, v7
    s_cmp_lt_u32 s2, 28
    s_cselect_b32 s24, 1, 0
    s_cmp_eq_u32 s22, 3
    s_cselect_b32 s63, s24, 0
    v_and_b32 v7, 1, v3
    v_lshlrev_b32 v7, 9, v7
    v_lshlrev_b32 v8, 4, v2
    v_add_u32 v7, v7, v8
    v_add_u32 v144, 147456, v7
    v_xor_b32 v7, v2, v3
    v_lshlrev_b32 v7, 4, v7
    v_lshlrev_b32 v8, 9, v3
    s_lshl_b32 s24, s22, 14
    v_add_u32 v8, s24, v8
    v_xor_b32 v9, 0, v7
    v_add_u32 v112, v8, v9
    v_xor_b32 v9, 64, v7
    v_add_u32 v113, v8, v9
    v_xor_b32 v9, 128, v7
    v_add_u32 v114, v8, v9
    v_xor_b32 v9, 192, v7
    v_add_u32 v115, v8, v9
    v_xor_b32 v9, 256, v7
    v_add_u32 v116, v8, v9
    v_xor_b32 v9, 320, v7
    v_add_u32 v117, v8, v9
    v_xor_b32 v9, 384, v7
    v_add_u32 v118, v8, v9
    v_xor_b32 v9, 448, v7
    v_add_u32 v119, v8, v9
    s_mov_b32 s48, 0
L_spin_12:
    ds_read_b32 v7, v4 offset:64
    s_waitcnt lgkmcnt(0)
    v_readfirstlane_b32 s49, v7
    s_cmp_ge_u32 s49, 1
    s_cbranch_scc1 L_spun_13
    s_add_u32 s48, s48, 1
    s_cmp_lt_u32 s48, 65536
    s_sleep 1
    s_cbranch_scc1 L_spin_12
L_spun_13:
    s_mov_b32 s48, 0
L_spin_14:
    ds_read_b32 v7, v4 offset:12
    s_waitcnt lgkmcnt(0)
    v_readfirstlane_b32 s49, v7
    s_cmp_ge_u32 s49, 4
    s_cbranch_scc1 L_spun_15
    s_add_u32 s48, s48, 1
    s_cmp_lt_u32 s48, 18
    s_sleep 1
    s_cbranch_scc1 L_spin_14
L_spun_15:
    s_mov_b32 s59, s58
    s_add_u32 s60, s59, 4096
    s_add_u32 s61, s59, 8192
    s_add_u32 s27, s59, 12288
    buffer_load_dwordx4 v[16:19], v10, s[28:31], s59 offen nt
    buffer_load_dwordx4 v[20:23], v10, s[28:31], s60 offen nt
    buffer_load_dwordx4 v[24:27], v10, s[28:31], s61 offen nt
    buffer_load_dwordx4 v[28:31], v10, s[28:31], s27 offen nt
    s_mov_b32 s48, 0
L_spin_21:
    ds_read_b32 v7, v4 offset:12
    s_waitcnt lgkmcnt(0)
    v_readfirstlane_b32 s49, v7
    s_cmp_ge_u32 s49, 8
    s_cbranch_scc1 L_spun_22
    s_add_u32 s48, s48, 1
    s_cmp_lt_u32 s48, 9
    s_sleep 1
    s_cbranch_scc1 L_spin_21
L_spun_22:
    s_add_u32 s60, s59, 4096
    s_add_u32 s61, s59, 8192
    s_add_u32 s27, s59, 12288
    buffer_load_dwordx4 v[160:163], v10, s[28:31], s59 offen nt
    buffer_load_dwordx4 v[164:167], v10, s[28:31], s60 offen nt
    buffer_load_dwordx4 v[168:171], v10, s[28:31], s61 offen nt
    buffer_load_dwordx4 v[172:175], v10, s[28:31], s27 offen nt
    s_waitcnt vmcnt(4)
    v_max3_u32 v7, v17, v19, v21
    v_min3_u32 v8, v17, v19, v21
    v_max3_u32 v7, v7, v23, v25
    v_min3_u32 v8, v8, v23, v25
    v_max3_u32 v7, v7, v27, v29
    v_min3_u32 v8, v8, v27, v29
    v_max_u32 v7, v7, v31
    v_min_u32 v8, v8, v31
    v_xor_b32 v7, s23, v7
    v_xor_b32 v8, s23, v8
    v_or_b32 v7, v7, v8
    v_cmp_ne_u32 vcc, 0, v7
    s_mov_b32 s48, 0
    s_cbranch_vccz L_qgd_17
    s_waitcnt vmcnt(0)
    v_max3_u32 v7, v161, v163, v165
    v_min3_u32 v8, v161, v163, v165
    v_max3_u32 v7, v7, v167, v169
    v_min3_u32 v8, v8, v167, v169
    v_max3_u32 v7, v7, v171, v173
    v_min3_u32 v8, v8, v171, v173
    v_max_u32 v7, v7, v175
    v_min_u32 v8, v8, v175
    v_xor_b32 v7, s23, v7
    v_xor_b32 v8, s23, v8
    v_or_b32 v7, v7, v8
    v_cmp_ne_u32 vcc, 0, v7
    s_mov_b32 s48, 2
    s_cbranch_vccnz L_qgf_20
    s_mov_b32 s48, 0
    v_mov_b32 v16, v160
    v_mov_b32 v17, v161
    v_mov_b32 v18, v162
    v_mov_b32 v19, v163
    v_mov_b32 v20, v164
    v_mov_b32 v21, v165
    v_mov_b32 v22, v166
    v_mov_b32 v23, v167
    v_mov_b32 v24, v168
    v_mov_b32 v25, v169
    v_mov_b32 v26, v170
    v_mov_b32 v27, v171
    v_mov_b32 v28, v172
    v_mov_b32 v29, v173
    v_mov_b32 v30, v174
    v_mov_b32 v31, v175
    s_branch L_qgd_17
L_qg_16:
    s_add_u32 s60, s59, 4096
    s_add_u32 s61, s59, 8192
    s_add_u32 s27, s59, 12288
    buffer_load_dwordx4 v[16:19], v10, s[28:31], s59 offen sc1
    buffer_load_dwordx4 v[20:23], v10, s[28:31], s60 offen sc1
    buffer_load_dwordx4 v[24:27], v10, s[28:31], s61 offen sc1
    buffer_load_dwordx4 v[28:31], v10, s[28:31], s27 offen sc1
    s_waitcnt vmcnt(0)
    v_max3_u32 v7, v17, v19, v21
    v_min3_u32 v8, v17, v19, v21
    v_max3_u32 v7, v7, v23, v25
    v_min3_u32 v8, v8, v23, v25
    v_max3_u32 v7, v7, v27, v29
    v_min3_u32 v8, v8, v27, v29
    v_max_u32 v7, v7, v31
    v_min_u32 v8, v8, v31
    v_xor_b32 v7, s23, v7
    v_xor_b32 v8, s23, v8
    v_or_b32 v7, v7, v8
    v_cmp_ne_u32 vcc, 0, v7
    s_cbranch_vccz L_qgd_17
    L_qgf_20:
    s_add_u32 s48, s48, 1
    s_cmp_lt_u32 s48, 3
    s_cbranch_scc1 L_qgn_19
    s_mov_b64 exec, 1
    ds_write_b32 v4, v5 offset:52
    s_mov_b64 exec, -1
    s_cmp_eq_u32 s62, 0
    s_cbranch_scc1 L_pub_23
    s_add_u32 s24, s98, 323584
    buffer_store_dwordx2 v[150:151], v152, s[28:31], s24 offen sc1
    s_mov_b32 s62, 0
L_pub_23:
    s_bitcmp0_b32 s48, 0
    s_cselect_b32 s24, 323584, 0
    s_add_u32 s59, s58, s24
    L_qgn_19:
    s_cmp_lt_u32 s48, 16384
    s_sleep 4
    s_cbranch_scc1 L_qg_16
    L_qgd_17:
    v_or3_b32 v7, v16, v18, v20
    v_bitop3_b32 v8, v16, v18, v20 bitop3:0x80
    v_or3_b32 v7, v7, v22, v24
    v_bitop3_b32 v8, v8, v22, v24 bitop3:0x80
    v_or3_b32 v7, v7, v26, v28
    v_bitop3_b32 v8, v8, v26, v28 bitop3:0x80
    v_or_b32 v7, v7, v30
    v_and_b32 v8, v8, v30
    v_xor_b32 v7, s96, v7
    v_xor_b32 v8, s96, v8
    v_or_b32 v7, v7, v8
    v_and_b32 v7, 7, v7
    v_cmp_ne_u32 vcc, 0, v7
    v_add_f32 v16, v16, v20
    v_add_f32 v18, v18, v22
    v_add_f32 v24, v24, v28
    v_add_f32 v26, v26, v30
    v_add_f32 v16, v16, v24
    v_add_f32 v18, v18, v26
    v_cvt_pk_bf16_f32 v7, v16, v18
    v_lshlrev_b32 v8, 2, v1
    s_lshl_b32 s24, s22, 8
    s_add_u32 s24, s24, 147456
    v_add_u32 v8, s24, v8
    ds_write_b32 v8, v7
    s_cbranch_vccz L_qgu_18
    s_mov_b64 exec, 1
    ds_write_b32 v4, v5 offset:40
    s_mov_b64 exec, -1
L_qgu_18:
    s_mov_b64 exec, 1
    ds_add_u32 v4, v5 offset:0
    s_mov_b64 exec, -1
    s_cmp_eq_u32 s63, 0
    s_cbranch_scc1 L_nord_24
    buffer_load_dwordx2 v[146:147], v148, s[28:31], 0 offen sc1
L_nord_24:
    s_lshl_b32 s24, s22, 2
    v_add_u32 v7, s24, v4
    s_mov_b32 s48, 0
L_spin_25:
    ds_read_b32 v9, v7 offset:24
    s_waitcnt lgkmcnt(0)
    v_readfirstlane_b32 s49, v9
    s_cmp_ge_u32 s49, 1
    s_cbranch_scc1 L_spun_26
    s_add_u32 s48, s48, 1
    s_cmp_lt_u32 s48, 65536
    s_sleep 1
    s_cbranch_scc1 L_spin_25
L_spun_26:
    ds_read_b128 v[48:51], v112 offset:0
    ds_read_b128 v[52:55], v113 offset:0
    ds_read_b128 v[56:59], v114 offset:0
    ds_read_b128 v[60:63], v115 offset:0
    ds_read_b128 v[64:67], v116 offset:0
    ds_read_b128 v[68:71], v117 offset:0
    ds_read_b128 v[72:75], v118 offset:0
    ds_read_b128 v[76:79], v119 offset:0
    ds_read_b128 v[80:83], v112 offset:8192
    ds_read_b128 v[84:87], v113 offset:8192
    ds_read_b128 v[88:91], v114 offset:8192
    ds_read_b128 v[92:95], v115 offset:8192
    ds_read_b128 v[96:99], v116 offset:8192
    ds_read_b128 v[100:103], v117 offset:8192
    ds_read_b128 v[104:107], v118 offset:8192
    s_waitcnt lgkmcnt(8)
    ds_read_b128 v[108:111], v119 offset:8192
    s_mov_b32 s48, 0
L_qw_27:
    ds_read_b32 v8, v4 offset:0
    ds_read_b32 v9, v4 offset:52
    s_waitcnt lgkmcnt(0)
    v_readfirstlane_b32 s49, v8
    v_readfirstlane_b32 s99, v9
    s_cmp_ge_u32 s49, 4
    s_cbranch_scc1 L_qwd_28
    s_cmp_eq_u32 s99, 0
    s_cbranch_scc1 L_qw2_29
    s_cmp_eq_u32 s62, 0
    s_cbranch_scc1 L_pub_30
    s_add_u32 s24, s98, 323584
    buffer_store_dwordx2 v[150:151], v152, s[28:31], s24 offen sc1
    s_mov_b32 s62, 0
L_pub_30:
L_qw2_29:
    s_add_u32 s48, s48, 1
    s_cmp_lt_u32 s48, 65536
    s_sleep 1
    s_cbranch_scc1 L_qw_27
L_qwd_28:
    ds_read_b32 v149, v4 offset:40
    ds_read_b128 v[16:19], v144 offset:0
    ds_read_b128 v[20:23], v144 offset:64
    ds_read_b128 v[24:27], v144 offset:128
    ds_read_b128 v[28:31], v144 offset:192
    ds_read_b128 v[32:35], v144 offset:256
    ds_read_b128 v[36:39], v144 offset:320
    ds_read_b128 v[40:43], v144 offset:384
    ds_read_b128 v[44:47], v144 offset:448
    s_waitcnt lgkmcnt(7)
    v_mfma_f32_16x16x32_bf16 v[120:123], v[48:51], v[16:19], 0
    v_mfma_f32_16x16x32_bf16 v[124:127], v[80:83], v[16:19], 0
    s_waitcnt lgkmcnt(6)
    v_mfma_f32_16x16x32_bf16 v[120:123], v[52:55], v[20:23], v[120:123]
    v_mfma_f32_16x16x32_bf16 v[124:127], v[84:87], v[20:23], v[124:127]
    s_waitcnt lgkmcnt(5)
    v_mfma_f32_16x16x32_bf16 v[120:123], v[56:59], v[24:27], v[120:123]
    v_mfma_f32_16x16x32_bf16 v[124:127], v[88:91], v[24:27], v[124:127]
    s_waitcnt lgkmcnt(4)
    v_mfma_f32_16x16x32_bf16 v[120:123], v[60:63], v[28:31], v[120:123]
    v_mfma_f32_16x16x32_bf16 v[124:127], v[92:95], v[28:31], v[124:127]
    s_waitcnt lgkmcnt(3)
    v_mfma_f32_16x16x32_bf16 v[120:123], v[64:67], v[32:35], v[120:123]
    v_mfma_f32_16x16x32_bf16 v[124:127], v[96:99], v[32:35], v[124:127]
    s_waitcnt lgkmcnt(2)
    v_mfma_f32_16x16x32_bf16 v[120:123], v[68:71], v[36:39], v[120:123]
    v_mfma_f32_16x16x32_bf16 v[124:127], v[100:103], v[36:39], v[124:127]
    s_waitcnt lgkmcnt(1)
    v_mfma_f32_16x16x32_bf16 v[120:123], v[72:75], v[40:43], v[120:123]
    v_mfma_f32_16x16x32_bf16 v[124:127], v[104:107], v[40:43], v[124:127]
    s_waitcnt lgkmcnt(0)
    v_mfma_f32_16x16x32_bf16 v[120:123], v[76:79], v[44:47], v[120:123]
    v_mfma_f32_16x16x32_bf16 v[124:127], v[108:111], v[44:47], v[124:127]
    v_readfirstlane_b32 s97, v149
    v_lshlrev_b32 v7, 1, v2
    v_add_u32 v7, s56, v7
    v_add_u32 v8, 8, v7
    v_and_b32 v7, 15, v7
    v_and_b32 v8, 15, v8
    v_lshlrev_b32 v7, 2, v7
    v_lshlrev_b32 v8, 2, v8
    v_and_b32 v9, 1, v3
    v_lshlrev_b32 v14, 4, v9
    v_add_u32 v14, 148992, v14
    s_lshl_b32 s24, s22, 2
    v_add_u32 v15, s24, v14
    v_lshlrev_b32 v9, 8, v9
    s_lshl_b32 s24, s22, 6
    s_add_u32 s24, s24, 148480
    v_add_u32 v9, s24, v9
    v_add_u32 v10, v9, v7
    v_add_u32 v11, v9, v8
    s_mov_b32 s25, 0xffff0000
    s_mov_b32 s26, 0x3db8aa3b
    v_cvt_pk_bf16_f32 v136, v120, v121
    v_cvt_pk_bf16_f32 v137, v122, v123
    v_cvt_pk_bf16_f32 v138, v124, v125
    v_cvt_pk_bf16_f32 v139, v126, v127
    v_lshlrev_b32 v128, 16, v136
    v_and_b32 v129, s25, v136
    v_lshlrev_b32 v130, 16, v137
    v_and_b32 v131, s25, v137
    v_lshlrev_b32 v132, 16, v138
    v_and_b32 v133, s25, v138
    v_lshlrev_b32 v134, 16, v139
    v_and_b32 v135, s25, v139
    v_max3_f32 v12, v128, v129, v130
    v_max3_f32 v8, v131, v132, v133
    v_max3_f32 v12, v12, v134, v135
    v_max_f32 v12, v12, v8
    v_mov_b32 v7, v12
    s_nop 1
    v_permlane16_swap_b32 v12, v7
    v_max_f32 v12, v12, v7
    v_mov_b32 v7, v12
    s_nop 1
    v_permlane32_swap_b32 v12, v7
    v_max_f32 v12, v12, v7
    s_mov_b64 exec, 3
    ds_write_b32 v15, v12
    s_mov_b64 exec, -1
    s_mov_b32 s48, 0
    L_mx_31:
    ds_read_b128 v[16:19], v14
    s_add_u32 s48, s48, 1
    s_waitcnt lgkmcnt(0)
    v_max3_u32 v7, v16, v17, v18
    v_max_u32 v7, v7, v19
    v_cmp_eq_u32 vcc, -1, v7
    s_cbranch_vccz L_mxd_32
    s_cmp_lt_u32 s48, 65536
    s_cbranch_scc1 L_mx_31
    L_mxd_32:
    v_max3_f32 v16, v16, v17, v18
    v_max_f32 v16, v16, v19
    v_mul_f32 v12, s26, v16
    v_fma_f32 v136, v128, s26, -v12
    v_fma_f32 v137, v129, s26, -v12
    v_fma_f32 v138, v130, s26, -v12
    v_fma_f32 v139, v131, s26, -v12
    v_fma_f32 v140, v132, s26, -v12
    v_fma_f32 v141, v133, s26, -v12
    v_fma_f32 v142, v134, s26, -v12
    v_fma_f32 v143, v135, s26, -v12
    v_exp_f32 v136, v136
    v_exp_f32 v137, v137
    v_exp_f32 v138, v138
    v_exp_f32 v139, v139
    v_exp_f32 v140, v140
    v_exp_f32 v141, v141
    v_exp_f32 v142, v142
    v_exp_f32 v143, v143
    s_nop 0
    v_cvt_pk_bf16_f32 v16, v136, v137
    v_cvt_pk_bf16_f32 v17, v138, v139
    v_cvt_pk_bf16_f32 v18, v140, v141
    v_cvt_pk_bf16_f32 v19, v142, v143
    v_add_f32 v7, v136, v137
    v_add_f32 v8, v138, v139
    v_add_f32 v9, v140, v141
    v_add_f32 v13, v142, v143
    s_mov_b32 exec_lo, 0x30003
    s_mov_b32 exec_hi, 0x30003
    ds_write_b64 v10, v[16:17]
    ds_write_b64 v11, v[18:19]
    s_mov_b64 exec, -1
    v_add_f32 v7, v7, v8
    v_add_f32 v13, v13, v9
    v_add_f32 v13, v13, v7
    v_mov_b32 v7, v13
    s_nop 1
    v_permlane16_swap_b32 v13, v7
    v_add_f32 v13, v13, v7
    v_mov_b32 v7, v13
    s_nop 1
    v_permlane32_swap_b32 v13, v7
    v_add_f32 v13, v13, v7
    s_mov_b64 exec, 3
    ds_write_b32 v15, v13 offset:32
    s_mov_b64 exec, -1
    s_cmp_lg_u32 s22, 0
    s_cbranch_scc1 L_nopub_33
    v_lshlrev_b32 v9, 8, v1
    s_lshl_b32 s27, s20, 6
    s_add_u32 s27, s27, s21
    s_lshl_b32 s27, s27, 3
    s_add_u32 s27, s27, 147456
    s_mov_b32 s48, 0
    L_sp_34:
    ds_read_b128 v[16:19], v14 offset:32
    s_add_u32 s48, s48, 1
    s_waitcnt lgkmcnt(0)
    v_max3_u32 v7, v16, v17, v18
    v_max_u32 v7, v7, v19
    v_cmp_eq_u32 vcc, -1, v7
    s_cbranch_vccz L_spd_35
    s_cmp_lt_u32 s48, 65536
    s_cbranch_scc1 L_sp_34
    L_spd_35:
    v_add_f32 v16, v16, v17
    v_add_f32 v18, v18, v19
    v_add_f32 v13, v16, v18
    s_cmp_lg_u32 s97, 0
    s_cbranch_scc1 L_sps_36
    s_mov_b64 exec, 3
    buffer_store_dwordx2 v[12:13], v9, s[28:31], s27 offen
    s_mov_b64 exec, -1
    s_branch L_nopub_33
    L_sps_36:
    s_mov_b32 s48, 0
L_spin_38:
    ds_read_b32 v7, v4 offset:44
    s_waitcnt lgkmcnt(0)
    v_readfirstlane_b32 s49, v7
    s_cmp_ge_u32 s49, 1
    s_cbranch_scc1 L_spun_39
    s_add_u32 s48, s48, 1
    s_cmp_lt_u32 s48, 65536
    s_sleep 1
    s_cbranch_scc1 L_spin_38
L_spun_39:
    s_add_u32 s27, s27, 4096
    s_mov_b64 exec, 3
    buffer_store_dwordx2 v[12:13], v9, s[28:31], s27 offen sc1
    s_mov_b64 exec, -1
    L_nopub_33:
    s_cmp_eq_u32 s63, 0
    s_cbranch_scc1 L_nordc_40
    s_mov_b32 s48, 0
L_rd_41:
    s_waitcnt vmcnt(0)
    v_cmp_ne_u32 vcc, s23, v147
    s_cbranch_vccz L_nordc_40
    s_add_u32 s48, s48, 1
    s_cmp_lt_u32 s48, 16384
    s_cbranch_scc0 L_nordc_40
    s_sleep 4
    buffer_load_dwordx2 v[146:147], v148, s[28:31], 0 offen sc1
    s_branch L_rd_41
    L_nordc_40:
    s_cmp_eq_u32 s97, 0
    s_cbranch_scc1 L_slowend_43
    s_cmp_lg_u32 s22, 1
    s_cbranch_scc1 L_slow2_44
    v_mov_b32 v16, -1
    v_mov_b32 v17, -1
    v_mov_b32 v18, -1
    v_mov_b32 v19, -1
    v_lshrrev_b32 v7, 2, v1
    v_and_b32 v8, 3, v1
    v_lshlrev_b32 v8, 4, v8
    v_lshl_add_u32 v7, v7, 11, v8
    v_lshlrev_b32 v9, 8, v1
    s_lshl_b32 s24, s20, 10
    s_add_u32 s24, s24, s21
    s_lshl_b32 s24, s24, 6
    s_add_u32 s24, s24, 1048576
    s_lshl_b32 s25, s20, 6
    s_add_u32 s25, s25, s21
    s_lshl_b32 s25, s25, 3
    s_add_u32 s25, s25, 151552
    buffer_store_dwordx4 v[16:19], v7, s[28:31], s24 offen sc1
    s_add_u32 s24, s24, 32768
    buffer_store_dwordx4 v[16:19], v7, s[28:31], s24 offen sc1
    s_mov_b64 exec, 3
    buffer_store_dwordx2 v[16:17], v9, s[28:31], s25 offen sc1
    s_mov_b64 exec, -1
    s_waitcnt vmcnt(0)
    s_mov_b64 exec, 1
    ds_add_u32 v4, v5 offset:44
    s_mov_b64 exec, -1
    s_mov_b64 exec, 1
    v_mov_b32 v16, 0
    v_mov_b32 v17, s23
    v_mov_b32 v7, 0
    s_lshl_b32 s24, s20, 8
    s_lshl_b32 s25, s21, 3
    s_add_u32 s24, s24, s25
    s_add_u32 s24, s24, 143360
    buffer_store_dwordx2 v[16:17], v7, s[28:31], s24 offen sc1
    s_mov_b64 exec, -1
    s_branch L_slowend_43
    L_slow2_44:
    s_cmp_lg_u32 s22, 2
    s_cbranch_scc1 L_slowend_43
    v_and_b32 v7, 31, v1
    v_lshlrev_b32 v7, 3, v7
    s_lshl_b32 s24, s20, 8
    s_add_u32 s24, s24, 143360
    s_mov_b32 s48, 0
    L_r2_45:
    buffer_load_dwordx2 v[16:17], v7, s[28:31], s24 offen sc1
    s_waitcnt vmcnt(0)
    v_cmp_ne_u32 vcc, s23, v17
    s_cbranch_vccz L_r2d_46
    s_add_u32 s48, s48, 1
    s_cmp_lt_u32 s48, 16384
    s_sleep 4
    s_cbranch_scc1 L_r2_45
    L_r2d_46:
    s_mov_b64 exec, 1
    ds_add_u32 v4, v5 offset:20
    s_mov_b64 exec, -1
L_slowend_43:
    v_lshrrev_b32 v7, 2, v1
    v_lshlrev_b32 v8, 8, v7
    v_and_b32 v7, 7, v7
    v_lshlrev_b32 v7, 1, v7
    v_bfe_u32 v9, v1, 1, 1
    v_xor_b32 v7, v7, v9
    v_and_b32 v9, 1, v1
    v_lshlrev_b32 v9, 3, v9
    v_add_u32 v8, v8, v9
    v_add_u32 v8, 131072, v8
    s_lshl_b32 s24, s22, 2
    v_xor_b32 v9, s24, v7
    v_lshlrev_b32 v9, 4, v9
    v_add_u32 v15, v8, v9
    s_add_u32 s24, s24, 2
    v_xor_b32 v9, s24, v7
    v_lshlrev_b32 v9, 4, v9
    v_add_u32 v16, v8, v9
    v_lshrrev_b32 v7, 2, v1
    v_lshlrev_b32 v10, 3, v7
    v_lshlrev_b32 v7, 7, v7
    v_and_b32 v8, 3, v1
    v_lshlrev_b32 v8, 4, v8
    v_add_u32 v11, v7, v8
    v_lshlrev_b32 v17, 4, v1
    v_and_b32 v7, 3, v1
    v_lshlrev_b32 v7, 2, v7
    v_add_u32 v7, v7, v2
    v_lshlrev_b32 v7, 1, v7
    v_mov_b32 v21, v7
    s_lshl_b32 s24, s22, 5
    s_add_u32 s24, s24, 149056
    v_add_u32 v18, s24, v7
    v_lshlrev_b32 v7, 3, v2
    v_add_u32 v19, 149056, v7
    v_and_b32 v7, 1, v3
    v_lshlrev_b32 v7, 6, v7
    v_lshlrev_b32 v8, 4, v2
    v_add_u32 v20, v7, v8
    s_lshl_b32 s59, s20, 16
    s_lshr_b32 s24, s21, 2
    s_lshl_b32 s24, s24, 2
    s_add_u32 s24, s24, s22
    s_lshl_b32 s24, s24, 11
    s_add_u32 s59, s59, s24
    s_mul_i32 s24, s97, 524288
    s_add_u32 s59, s59, s24
    s_add_u32 s59, s59, 524288
    s_and_b32 s24, s21, 3
    s_lshl_b32 s24, s24, 2
    s_add_u32 s61, s24, s22
    s_lshl_b32 s60, s61, 13
    s_lshr_b32 s24, s21, 2
    s_lshl_b32 s25, s20, 3
    s_add_u32 s24, s24, s25
    s_lshl_b32 s24, s24, 7
    s_add_u32 s60, s60, s24
    s_add_u32 s60, s60, 196608
    s_mov_b32 s50, 0x00020002
    s_mov_b32 s51, 0x00020002
    s_lshr_b32 s58, s2, 1
    s_lshl_b32 s58, s58, 13
    s_and_b32 s24, s2, 1
    s_lshl_b32 s24, s24, 6
    s_add_u32 s58, s58, s24
    s_add_u32 s58, s58, 196608
    s_add_u32 s98, s58, 4096
    s_lshl_b32 s99, s2, 5
    s_mov_b32 s44, s14
    s_and_b32 s45, s15, 0xffff
    s_mov_b32 s46, 896
    s_mov_b32 s47, 0x20000
    s_cmp_eq_u32 s97, 0
    s_cbranch_scc1 L_fe_47
    s_mov_b32 s48, 0
L_spin_48:
    ds_read_b32 v9, v4 offset:20
    s_waitcnt lgkmcnt(0)
    v_readfirstlane_b32 s49, v9
    s_cmp_ge_u32 s49, 1
    s_cbranch_scc1 L_spun_49
    s_add_u32 s48, s48, 1
    s_cmp_lt_u32 s48, 65536
    s_sleep 1
    s_cbranch_scc1 L_spin_48
L_spun_49:
L_fe_47:
    s_lshl_b32 s27, s20, 9
    s_lshr_b32 s24, s21, 4
    s_lshl_b32 s24, s24, 8
    s_add_u32 s27, s27, s24
    s_mul_i32 s24, s97, 4096
    s_add_u32 s27, s27, s24
    s_add_u32 s27, s27, 147456
    s_mov_b32 s48, 0
L_spin_50:
    ds_read_b32 v9, v4 offset:8
    s_waitcnt lgkmcnt(0)
    v_readfirstlane_b32 s49, v9
    s_cmp_ge_u32 s49, 4
    s_cbranch_scc1 L_spun_51
    s_add_u32 s48, s48, 1
    s_cmp_lt_u32 s48, 65536
    s_sleep 1
    s_cbranch_scc1 L_spin_50
L_spun_51:
    s_mov_b32 s48, 0
    L_stg_52:
    buffer_load_dwordx2 v[22:23], v10, s[28:31], s27 offen sc1
    buffer_load_dwordx2 v[24:25], v10, s[28:31], s27 offen offset:128 sc1
    s_add_u32 s48, s48, 1
    s_waitcnt vmcnt(0)
    v_max3_u32 v7, v22, v23, v24
    v_max_u32 v7, v7, v25
    v_cmp_eq_u32 vcc, -1, v7
    v_max_f32 v7, v22, v24
    s_cbranch_vccz L_stgd_53
    s_cmp_lt_u32 s48, 16384
    s_sleep 3
    s_cbranch_scc1 L_stg_52
    L_stgd_53:
    s_nop 0
    v_max_f32_dpp v7, v7, v7 row_ror:4 row_mask:0xf bank_mask:0xf
    s_nop 1
    v_max_f32_dpp v7, v7, v7 row_ror:8 row_mask:0xf bank_mask:0xf
    v_mov_b32 v8, v7
    s_nop 1
    v_permlane16_swap_b32 v7, v8
    v_max_f32 v7, v7, v8
    v_mov_b32 v8, v7
    s_nop 1
    v_permlane32_swap_b32 v7, v8
    v_max_f32 v7, v7, v8
    v_sub_f32 v26, v22, v7
    v_sub_f32 v27, v24, v7
    v_exp_f32 v26, v26
    v_exp_f32 v27, v27
    s_nop 0
    v_mul_f32 v7, v26, v23
    v_fmac_f32 v7, v27, v25
    s_nop 1
    v_add_f32_dpp v7, v7, v7 row_ror:4 row_mask:0xf bank_mask:0xf
    s_nop 1
    v_add_f32_dpp v7, v7, v7 row_ror:8 row_mask:0xf bank_mask:0xf
    v_mov_b32 v8, v7
    s_nop 1
    v_permlane16_swap_b32 v7, v8
    v_add_f32 v7, v7, v8
    v_mov_b32 v8, v7
    s_nop 1
    v_permlane32_swap_b32 v7, v8
    v_add_f32 v7, v7, v8
    v_rcp_f32 v7, v7
    s_nop 0
    v_mul_f32 v26, v26, v7
    v_mul_f32 v27, v27, v7
    s_mov_b32 s48, 0
L_spin_54:
    ds_read_b32 v9, v4 offset:16
    s_waitcnt lgkmcnt(0)
    v_readfirstlane_b32 s49, v9
    s_cmp_ge_u32 s49, 4
    s_cbranch_scc1 L_spun_55
    s_add_u32 s48, s48, 1
    s_cmp_lt_u32 s48, 65536
    s_cbranch_scc1 L_spin_54
L_spun_55:
    buffer_load_dwordx4 v[116:119], v17, s[28:31], s59 offen sc1
    buffer_load_dwordx4 v[120:123], v17, s[28:31], s59 offen offset:1024 sc1
    s_barrier
    ds_read_b64_tr_b16 v[36:37], v15 offset:0
    ds_read_b64_tr_b16 v[38:39], v15 offset:4096
    ds_read_b64_tr_b16 v[40:41], v15 offset:8192
    ds_read_b64_tr_b16 v[42:43], v15 offset:12288
    ds_read_b64_tr_b16 v[44:45], v16 offset:0
    ds_read_b64_tr_b16 v[46:47], v16 offset:4096
    ds_read_b64_tr_b16 v[48:49], v16 offset:8192
    ds_read_b64_tr_b16 v[50:51], v16 offset:12288
    s_mov_b32 s48, 0
L_ha_56:
    buffer_load_dwordx4 v[124:127], v17, s[28:31], s59 offen sc1
    buffer_load_dwordx4 v[128:131], v17, s[28:31], s59 offen offset:1024 sc1
    s_waitcnt vmcnt(2)
    v_max3_u32 v7, v116, v117, v118
    v_max3_u32 v8, v119, v120, v121
    v_max3_u32 v7, v7, v122, v123
    v_max_u32 v7, v7, v8
    v_cmp_eq_u32 vcc, -1, v7
    s_cbranch_vccz L_haa_58
    buffer_load_dwordx4 v[116:119], v17, s[28:31], s59 offen sc1
    buffer_load_dwordx4 v[120:123], v17, s[28:31], s59 offen offset:1024 sc1
    s_waitcnt vmcnt(2)
    v_max3_u32 v7, v124, v125, v126
    v_max3_u32 v8, v127, v128, v129
    v_max3_u32 v7, v7, v130, v131
    v_max_u32 v7, v7, v8
    v_cmp_eq_u32 vcc, -1, v7
    s_cbranch_vccz L_hab_59
    s_add_u32 s48, s48, 1
    s_cmp_lt_u32 s48, 16384
    s_cbranch_scc1 L_ha_56
    s_waitcnt vmcnt(0)
L_haa_58:
    v_mul_f32 v28, v26, v116
    v_mul_f32 v29, v26, v117
    v_mul_f32 v30, v26, v118
    v_mul_f32 v31, v26, v119
    v_fmac_f32 v28, v27, v120
    v_fmac_f32 v29, v27, v121
    v_fmac_f32 v30, v27, v122
    v_fmac_f32 v31, v27, v123
    s_branch L_had_57
L_hab_59:
    v_mul_f32 v28, v26, v124
    v_mul_f32 v29, v26, v125
    v_mul_f32 v30, v26, v126
    v_mul_f32 v31, v26, v127
    v_fmac_f32 v28, v27, v128
    v_fmac_f32 v29, v27, v129
    v_fmac_f32 v30, v27, v130
    v_fmac_f32 v31, v27, v131
    s_nop 0
L_had_57:
    s_nop 0
    v_permlane16_swap_b32 v28, v29
    v_permlane16_swap_b32 v30, v31
    v_add_f32 v28, v28, v29
    v_add_f32 v30, v30, v31
    s_nop 1
    v_permlane32_swap_b32 v28, v30
    v_add_f32 v28, v28, v30
    s_nop 1
    v_add_f32_dpp v28, v28, v28 row_ror:4 row_mask:0xf bank_mask:0xf
    s_nop 1
    v_add_f32_dpp v28, v28, v28 row_ror:8 row_mask:0xf bank_mask:0xf
    v_cvt_pk_bf16_f32 v28, v28, v28
    s_mov_b32 exec_lo, 0xf000f
    s_mov_b32 exec_hi, 0xf000f
    ds_write_b16 v18, v28
    s_mov_b64 exec, -1
    s_mov_b32 s48, 0
    L_os_60:
    ds_read2_b64 v[52:55], v19 offset0:0 offset1:4
    ds_read2_b64 v[56:59], v19 offset0:8 offset1:12
    s_add_u32 s48, s48, 1
    s_waitcnt lgkmcnt(0)
    v_max3_u32 v7, v52, v53, v54
    v_max3_u32 v8, v55, v56, v57
    v_max3_u32 v7, v7, v58, v59
    v_max_u32 v7, v7, v8
    v_cmp_eq_u32 vcc, -1, v7
    s_cbranch_vccz L_osd_61
    s_cmp_lt_u32 s48, 65536
    s_cbranch_scc1 L_os_60
    L_osd_61:
    v_mfma_f32_16x16x32_bf16 v[60:63], v[36:39], v[52:55], 0
    v_mfma_f32_16x16x32_bf16 v[64:67], v[44:47], v[52:55], 0
    v_mfma_f32_16x16x32_bf16 v[60:63], v[40:43], v[56:59], v[60:63]
    v_mfma_f32_16x16x32_bf16 v[64:67], v[48:51], v[56:59], v[64:67]
    s_cmp_ge_u32 s61, 14
    s_cbranch_scc1 L_nohb_62
    s_nop 5
    v_cndmask_b32 v60, v60, v64, s[50:51]
    v_cndmask_b32 v61, v61, v65, s[50:51]
    v_cndmask_b32 v62, v62, v66, s[50:51]
    v_cndmask_b32 v63, v63, v67, s[50:51]
    s_mov_b32 exec_lo, 0x30003
    s_mov_b32 exec_hi, 0x30003
    buffer_store_dwordx4 v[60:63], v20, s[28:31], s60 offen sc1
    s_mov_b64 exec, -1
L_nohb_62:
    s_cmp_eq_u32 s63, 0
    s_cbranch_scc1 L_fin
    s_sleep 14
    s_mov_b32 s48, 0
L_fb_63:
    buffer_load_dwordx4 v[28:31], v11, s[28:31], s58 offen offset:0 sc1
    buffer_load_dwordx4 v[32:35], v11, s[28:31], s58 offen offset:2048 sc1
    buffer_load_dwordx4 v[36:39], v11, s[28:31], s98 offen offset:0 sc1
    buffer_load_dwordx4 v[40:43], v11, s[28:31], s98 offen offset:2048 sc1
    s_waitcnt vmcnt(0)
    v_max3_u32 v7, v28, v29, v30
    v_max3_u32 v8, v31, v32, v33
    v_max3_u32 v9, v34, v35, v36
    v_max3_u32 v7, v7, v37, v38
    v_max3_u32 v8, v8, v39, v40
    v_max3_u32 v9, v9, v41, v42
    v_max3_u32 v7, v7, v8, v43
    v_max_u32 v7, v7, v9
    v_cmp_eq_u32 vcc, -1, v7
    s_cbranch_vccz L_fbok_64
    s_add_u32 s48, s48, 1
    s_cmp_lt_u32 s48, 16384
    s_cbranch_scc1 L_fb_63
    s_waitcnt vmcnt(0)
L_fbok_64:
    v_add_f32 v28, v28, v32
    v_add_f32 v36, v36, v40
    v_add_f32 v29, v29, v33
    v_add_f32 v37, v37, v41
    v_add_f32 v30, v30, v34
    v_add_f32 v38, v38, v42
    v_add_f32 v31, v31, v35
    v_add_f32 v39, v39, v43
    v_add_f32 v28, v28, v36
    v_add_f32 v29, v29, v37
    v_add_f32 v30, v30, v38
    v_add_f32 v31, v31, v39
    s_nop 0
    v_permlane16_swap_b32 v28, v29
    v_permlane16_swap_b32 v30, v31
    v_add_f32 v28, v28, v29
    v_add_f32 v30, v30, v31
    s_nop 1
    v_permlane32_swap_b32 v28, v30
    v_add_f32 v28, v28, v30
    s_nop 1
    v_add_f32_dpp v28, v28, v28 row_ror:4 row_mask:0xf bank_mask:0xf
    s_nop 1
    v_add_f32_dpp v28, v28, v28 row_ror:8 row_mask:0xf bank_mask:0xf
    v_cvt_pk_bf16_f32 v28, v28, v28
    s_mov_b32 exec_lo, 0xf000f
    s_mov_b32 exec_hi, 0xf000f
    buffer_store_short v28, v21, s[44:47], s99 offen
L_epoch_65:
    s_cmp_lg_u32 s2, 0
    s_cbranch_scc1 L_fin
    s_mov_b64 exec, 1
    v_mov_b32 v8, s23
    v_mov_b32 v9, 0
    buffer_store_dword v8, v9, s[28:31], 0 offen sc1
L_fin:
    s_mov_b64 exec, -1
    s_endpgm
L_l_setup:
    v_lshrrev_b32 v14, 4, v1
    v_and_b32 v15, 15, v1
    s_add_u32 s60, s59, 65536
    s_and_b32 s57, s21, 15
    v_lshrrev_b32 v7, 2, v1
    v_and_b32 v8, 7, v7
    v_lshrrev_b32 v7, 5, v1
    v_lshlrev_b32 v7, 10, v7
    v_lshlrev_b32 v9, 7, v8
    v_add_u32 v7, v7, v9
    v_and_b32 v9, 1, v1
    v_lshlrev_b32 v9, 3, v9
    v_add_u32 v7, v7, v9
    v_add_u32 v7, s60, v7
    v_and_b32 v8, 6, v8
    v_bfe_u32 v9, v1, 1, 1
    v_or_b32 v8, v8, v9
    v_xor_b32 v9, 0, v8
    v_lshlrev_b32 v9, 4, v9
    v_add_u32 v10, v7, v9
    v_xor_b32 v9, 2, v8
    v_lshlrev_b32 v9, 4, v9
    v_add_u32 v11, v7, v9
    v_xor_b32 v9, 4, v8
    v_lshlrev_b32 v9, 4, v9
    v_add_u32 v12, v7, v9
    v_xor_b32 v9, 6, v8
    v_lshlrev_b32 v9, 4, v9
    v_add_u32 v13, v7, v9
    v_lshrrev_b32 v7, 1, v14
    v_add_u32 v7, s57, v7
    v_and_b32 v8, 1, v14
    v_lshlrev_b32 v8, 3, v8
    v_and_b32 v9, 1, v15
    v_lshlrev_b32 v4, 8, v9
    v_add_u32 v8, v8, v4
    v_add_u32 v8, 148480, v8
    v_lshlrev_b32 v9, 4, v9
    v_add_u32 v125, 148992, v9
    v_add_u32 v4, 0, v7
    v_and_b32 v4, 15, v4
    v_lshlrev_b32 v4, 4, v4
    v_add_u32 v116, v4, v8
    v_add_u32 v4, 2, v7
    v_and_b32 v4, 15, v4
    v_lshlrev_b32 v4, 4, v4
    v_add_u32 v117, v4, v8
    v_add_u32 v4, 4, v7
    v_and_b32 v4, 15, v4
    v_lshlrev_b32 v4, 4, v4
    v_add_u32 v118, v4, v8
    v_add_u32 v4, 6, v7
    v_and_b32 v4, 15, v4
    v_lshlrev_b32 v4, 4, v4
    v_add_u32 v119, v4, v8
    v_add_u32 v4, 8, v7
    v_and_b32 v4, 15, v4
    v_lshlrev_b32 v4, 4, v4
    v_add_u32 v120, v4, v8
    v_add_u32 v4, 10, v7
    v_and_b32 v4, 15, v4
    v_lshlrev_b32 v4, 4, v4
    v_add_u32 v121, v4, v8
    v_add_u32 v4, 12, v7
    v_and_b32 v4, 15, v4
    v_lshlrev_b32 v4, 4, v4
    v_add_u32 v122, v4, v8
    v_add_u32 v4, 14, v7
    v_and_b32 v4, 15, v4
    v_lshlrev_b32 v4, 4, v4
    v_add_u32 v123, v4, v8
    s_branch L_iss_3
L_l_rest:
    s_mov_b32 s28, s18
    s_and_b32 s29, s19, 0xffff
    s_mov_b32 s30, 1572864
    s_mov_b32 s31, 0x20000
    v_and_b32 v7, 1, v1
    v_lshlrev_b32 v7, 4, v7
    v_bfe_u32 v8, v1, 1, 2
    v_add_u32 v7, v7, v8
    v_lshlrev_b32 v7, 11, v7
    v_lshrrev_b32 v9, 4, v1
    v_lshl_add_u32 v124, v9, 4, v7
    s_lshl_b32 s61, s20, 16
    s_lshl_b32 s24, s22, 13
    s_add_u32 s61, s61, s24
    s_lshl_b32 s24, s21, 6
    s_add_u32 s61, s61, s24
    s_add_u32 s61, s61, 524288
    buffer_load_dwordx4 v[140:143], v124, s[28:31], s61 offen nt
    s_waitcnt vmcnt(13)
    ds_read_b64_tr_b16 v[32:33], v10 offset:0
    ds_read_b64_tr_b16 v[34:35], v10 offset:2048
    ds_read_b64_tr_b16 v[36:37], v11 offset:0
    ds_read_b64_tr_b16 v[38:39], v11 offset:2048
    ds_read_b64_tr_b16 v[40:41], v12 offset:0
    ds_read_b64_tr_b16 v[42:43], v12 offset:2048
    ds_read_b64_tr_b16 v[44:45], v13 offset:0
    ds_read_b64_tr_b16 v[46:47], v13 offset:2048
    s_waitcnt vmcnt(9)
    s_mov_b64 exec, 1
    ds_add_u32 v5, v6 offset:8
    s_mov_b64 exec, -1
    ds_read_b64_tr_b16 v[48:49], v10 offset:4096
    ds_read_b64_tr_b16 v[50:51], v10 offset:6144
    ds_read_b64_tr_b16 v[52:53], v11 offset:4096
    ds_read_b64_tr_b16 v[54:55], v11 offset:6144
    ds_read_b64_tr_b16 v[56:57], v12 offset:4096
    ds_read_b64_tr_b16 v[58:59], v12 offset:6144
    ds_read_b64_tr_b16 v[60:61], v13 offset:4096
    ds_read_b64_tr_b16 v[62:63], v13 offset:6144
    s_waitcnt vmcnt(5)
    s_mov_b32 s48, 0
L_spin_66:
    ds_read_b32 v4, v5 offset:64
    s_waitcnt lgkmcnt(0)
    v_readfirstlane_b32 s49, v4
    s_cmp_ge_u32 s49, 1
    s_cbranch_scc1 L_spun_67
    s_add_u32 s48, s48, 1
    s_cmp_lt_u32 s48, 65536
    s_sleep 1
    s_cbranch_scc1 L_spin_66
L_spun_67:
    v_lshrrev_b32 v8, 4, v1
    v_and_b32 v4, 15, v1
    v_lshlrev_b32 v7, 1, v8
    v_xor_b32 v7, v7, v4
    v_lshlrev_b32 v7, 4, v7
    v_mul_u32_u24 v8, 896, v8
    v_add_u32 v126, v7, v8
    v_xor_b32 v7, 128, v7
    v_add_u32 v127, v7, v8
    s_lshl_b32 s24, s20, 9
    s_lshr_b32 s25, s21, 2
    s_lshl_b32 s25, s25, 6
    s_add_u32 s24, s24, s25
    s_mul_i32 s24, s24, 896
    s_and_b32 s25, s21, 3
    s_lshl_b32 s25, s25, 8
    s_add_u32 s24, s24, s25
    s_add_u32 s40, s12, s24
    s_addc_u32 s41, s13, 0
    s_and_b32 s41, s41, 0xffff
    s_sub_u32 s42, 3670016, s24
    s_mov_b32 s43, 0x20000
    s_lshl_b32 s24, s22, 12
    s_add_u32 s24, s24, 131072
    s_mov_b32 m0, s24
    s_mul_i32 s25, s22, 14336
    buffer_load_dwordx4 v126, s[40:43], s25 offen nt lds
    s_add_u32 m0, m0, 1024
    s_add_u32 s25, s25, 3584
    buffer_load_dwordx4 v127, s[40:43], s25 offen nt lds
    s_add_u32 m0, m0, 1024
    s_add_u32 s25, s25, 3584
    buffer_load_dwordx4 v126, s[40:43], s25 offen nt lds
    s_add_u32 m0, m0, 1024
    s_add_u32 s25, s25, 3584
    buffer_load_dwordx4 v127, s[40:43], s25 offen nt lds
    ds_read_b64_tr_b16 v[64:65], v10 offset:8192
    ds_read_b64_tr_b16 v[66:67], v10 offset:10240
    ds_read_b64_tr_b16 v[68:69], v11 offset:8192
    ds_read_b64_tr_b16 v[70:71], v11 offset:10240
    ds_read_b64_tr_b16 v[72:73], v12 offset:8192
    ds_read_b64_tr_b16 v[74:75], v12 offset:10240
    ds_read_b64_tr_b16 v[76:77], v13 offset:8192
    ds_read_b64_tr_b16 v[78:79], v13 offset:10240
    s_mov_b32 s48, 0
L_pp_68:
    ds_read_b64 v[16:17], v116
    ds_read_b64 v[18:19], v117
    ds_read_b64 v[20:21], v118
    ds_read_b64 v[22:23], v119
    ds_read_b64 v[24:25], v120
    ds_read_b64 v[26:27], v121
    ds_read_b64 v[28:29], v122
    ds_read_b64 v[30:31], v123
    s_add_u32 s48, s48, 1
    s_waitcnt lgkmcnt(0)
    v_max3_u32 v7, v16, v17, v18
    v_max3_u32 v8, v19, v20, v21
    v_max3_u32 v7, v7, v22, v23
    v_max3_u32 v8, v8, v24, v25
    v_max3_u32 v7, v7, v26, v27
    v_max3_u32 v8, v8, v28, v29
    v_max3_u32 v7, v7, v30, v31
    v_max_u32 v7, v7, v8
    v_cmp_eq_u32 vcc, -1, v7
    s_cbranch_vccz L_ppd_69
    s_cmp_lt_u32 s48, 65536
    s_sleep 1
    s_cbranch_scc1 L_pp_68
    L_ppd_69:
    ds_read_b32 v136, v5 offset:40
    v_mfma_f32_16x16x32_bf16 v[96:99], v[32:35], v[16:19], 0
    v_mfma_f32_16x16x32_bf16 v[100:103], v[36:39], v[16:19], 0
    v_mfma_f32_16x16x32_bf16 v[104:107], v[40:43], v[16:19], 0
    v_mfma_f32_16x16x32_bf16 v[108:111], v[44:47], v[16:19], 0
    v_mfma_f32_16x16x32_bf16 v[96:99], v[48:51], v[20:23], v[96:99]
    v_mfma_f32_16x16x32_bf16 v[100:103], v[52:55], v[20:23], v[100:103]
    v_mfma_f32_16x16x32_bf16 v[104:107], v[56:59], v[20:23], v[104:107]
    v_mfma_f32_16x16x32_bf16 v[108:111], v[60:63], v[20:23], v[108:111]
    v_mfma_f32_16x16x32_bf16 v[96:99], v[64:67], v[24:27], v[96:99]
    v_mfma_f32_16x16x32_bf16 v[100:103], v[68:71], v[24:27], v[100:103]
    v_mfma_f32_16x16x32_bf16 v[104:107], v[72:75], v[24:27], v[104:107]
    v_mfma_f32_16x16x32_bf16 v[108:111], v[76:79], v[24:27], v[108:111]
    s_mov_b32 s50, 0xcccccccc
    s_mov_b32 s51, 0xcccccccc
    s_mov_b32 s52, 0xf0f0f0f0
    s_mov_b32 s53, 0xf0f0f0f0
    s_waitcnt lgkmcnt(0)
    v_readfirstlane_b32 s97, v136
    s_waitcnt vmcnt(5)
    ds_read_b64_tr_b16 v[80:81], v10 offset:12288
    ds_read_b64_tr_b16 v[82:83], v10 offset:14336
    ds_read_b64_tr_b16 v[84:85], v11 offset:12288
    ds_read_b64_tr_b16 v[86:87], v11 offset:14336
    ds_read_b64_tr_b16 v[88:89], v12 offset:12288
    ds_read_b64_tr_b16 v[90:91], v12 offset:14336
    ds_read_b64_tr_b16 v[92:93], v13 offset:12288
    ds_read_b64_tr_b16 v[94:95], v13 offset:14336
    s_waitcnt lgkmcnt(6)
    v_mfma_f32_16x16x32_bf16 v[96:99], v[80:83], v[28:31], v[96:99]
    s_waitcnt lgkmcnt(4)
    v_mfma_f32_16x16x32_bf16 v[100:103], v[84:87], v[28:31], v[100:103]
    s_waitcnt lgkmcnt(2)
    v_mfma_f32_16x16x32_bf16 v[104:107], v[88:91], v[28:31], v[104:107]
    s_waitcnt lgkmcnt(0)
    v_mfma_f32_16x16x32_bf16 v[108:111], v[92:95], v[28:31], v[108:111]
    s_nop 5
    v_cndmask_b32 v96, v96, v100, s[50:51]
    v_cndmask_b32 v97, v97, v101, s[50:51]
    v_cndmask_b32 v98, v98, v102, s[50:51]
    v_cndmask_b32 v99, v99, v103, s[50:51]
    v_cndmask_b32 v104, v104, v108, s[50:51]
    v_cndmask_b32 v105, v105, v109, s[50:51]
    v_cndmask_b32 v106, v106, v110, s[50:51]
    v_cndmask_b32 v107, v107, v111, s[50:51]
    v_cndmask_b32 v112, v96, v104, s[52:53]
    v_cndmask_b32 v113, v97, v105, s[52:53]
    v_cndmask_b32 v114, v98, v106, s[52:53]
    v_cndmask_b32 v115, v99, v107, s[52:53]
    s_mov_b32 exec_lo, 0xff00ff
    s_mov_b32 exec_hi, 0xff00ff
    s_cmp_lg_u32 s97, 0
    s_cbranch_scc1 L_slowst_70
    buffer_store_dwordx4 v[112:115], v124, s[28:31], s61 offen
L_std_71:
    s_mov_b64 exec, -1
    s_mov_b64 exec, 1
    ds_add_u32 v5, v6 offset:16
    s_mov_b64 exec, -1
    s_waitcnt vmcnt(1)
    s_barrier
    s_endpgm
L_slowst_70:
    s_mov_b64 exec, -1
    s_mov_b32 s48, 0
L_spin_72:
    ds_read_b32 v4, v5 offset:44
    s_waitcnt lgkmcnt(0)
    v_readfirstlane_b32 s49, v4
    s_cmp_ge_u32 s49, 1
    s_cbranch_scc1 L_spun_73
    s_add_u32 s48, s48, 1
    s_cmp_lt_u32 s48, 65536
    s_sleep 1
    s_cbranch_scc1 L_spin_72
L_spun_73:
    s_mov_b32 exec_lo, 0xff00ff
    s_mov_b32 exec_hi, 0xff00ff
    s_add_u32 s61, s61, 524288
    buffer_store_dwordx4 v[112:115], v124, s[28:31], s61 offen sc1
    s_branch L_std_71
L_end:
    s_endpgm

.section .rodata,"a"
.p2align 6
.amdhsa_kernel standalone__sliding_block_cached__decode_kernel
  .amdhsa_next_free_vgpr 176
  .amdhsa_next_free_sgpr 102
  .amdhsa_accum_offset 176
  .amdhsa_group_segment_fixed_size 0
  .amdhsa_kernarg_size 64
  .amdhsa_user_sgpr_count 2
  .amdhsa_user_sgpr_kernarg_segment_ptr 1
  .amdhsa_system_sgpr_workgroup_id_x 1
  .amdhsa_float_denorm_mode_32 3
.end_amdhsa_kernel
```
